```python
import torch

def _softmax(x, axis=-1):
    return torch.softmax(x, dim=axis)
def _gelu(x):
    return torch.nn.functional.gelu(x, approximate="tanh")
def _silu(x):
    return torch.nn.functional.silu(x)
def _sigmoid(x):
    return torch.sigmoid(x)
def _layernorm(x, axis=-1, eps=1e-5):
    m = x.mean(dim=axis, keepdim=True)
    v = x.var(dim=axis, keepdim=True, unbiased=False)
    return (x - m) / torch.sqrt(v + eps)
def _scatter_add(tgt, idx, src, axis=0):
    return tgt.clone().index_add_(axis, idx, src)
def _segment_sum(src, seg, n):
    out = torch.zeros((n,) + src.shape[1:], dtype=src.dtype)
    return out.index_add_(0, seg, src)
def _pad(x, pw):
    flat = tuple(v for pair in reversed(pw) for v in pair)
    return torch.nn.functional.pad(x, flat)

kernel_name = 'gather_scatter__spectral_conv_sgc__graph'

def setup_inputs():

    _w = (lambda a: (lambda t: t.to(torch.bfloat16) if t.is_floating_point() else t)(torch.as_tensor(a)))
    N, deg, D = 50000, 16, 64
    E = N * deg
    rs = (lambda lo, hi, *s: torch.randint(lo, hi, s))(0, N, E).to(torch.int64)
    rd = (lambda lo, hi, *s: torch.randint(lo, hi, s))(0, N, E).to(torch.int64)
    loop = torch.arange(N).to(torch.int64)
    src = torch.cat([rs, loop])
    dst = torch.cat([rd, loop])
    deg_cnt = torch.bincount(dst, minlength=N).to(float)
    dis = 1.0 / (lambda _x: torch.sqrt(torch.as_tensor(_x)))(deg_cnt)
    return {
        "x": _w((lambda *s: torch.randn(*s, dtype=torch.bfloat16) * 0.05)(N, D)),
        "src": _w(src),
        "dst": _w(dst),
        "norm": _w((dis[src] * dis[dst]).to(float)),
        "w": _w((lambda *s: torch.randn(*s, dtype=torch.bfloat16) * 0.05)(D, D)),
    }

def reference(x, src, dst, norm, w):
    N = x.shape[0]
    h = x
    for _ in range(2):
        msg = h[src] * norm[:, None]
        h = _segment_sum(msg, dst, N)
    return h @ w
```

```asm
; @launch kernel=sgc_part_kernel grid=(256,1,1) block=(896,1,1) lds=22016
; @launch kernel=sgc_prop_kernel grid=(256,1,1) block=(1024,1,1) lds=147456
.amdgcn_target "amdgcn-amd-amdhsa--gfx950"
.text
.globl sgc_part_kernel
.p2align 8
.type sgc_part_kernel,@function
sgc_part_kernel:
    s_cmp_ge_u32 s2, 256
    s_cbranch_scc1 K1_END
    s_load_dwordx2 s[10:11], s[0:1], 56
    v_readfirstlane_b32 s15, v0
    s_lshr_b32 s46, s15, 6
    s_cmp_lt_u32 s46, 13
    s_cbranch_scc1 K1_MAIN
    v_and_b32 v1, 63, v0
    v_mov_b32 v4, 0
    s_getpc_b64 s[48:49]
CPF_PC:
    s_add_u32 s48, s48, sgc_prop_kernel - CPF_PC
    s_addc_u32 s49, s49, 0
    v_lshlrev_b32 v7, 7, v1
    s_mov_b64 s[12:13], exec
    s_cmp_ge_u32 s2, 16
    s_cbranch_scc1 K1_NOCPF
    v_cmp_gt_u32 vcc, K2_CODE_END - sgc_prop_kernel, v7
    s_and_b64 exec, exec, vcc
    s_cbranch_execz K1_NOCPF0
    global_load_dword v8, v7, s[48:49]
K1_NOCPF0:
    s_mov_b64 exec, s[12:13]
K1_NOCPF:
    s_waitcnt lgkmcnt(0)
    s_cmp_lg_u32 s2, 0
    s_cbranch_scc1 K1_NOZ
    v_add_u32 v7, 1966080, v7
    global_store_dword v7, v4, s[10:11] sc1
K1_NOZ:
    s_mov_b32 s28, s10
    s_and_b32 s29, s11, 0xffff
    s_mov_b32 s30, 262144
    s_mov_b32 s31, 0x20000
    v_lshlrev_b32 v5, 4, v1
    s_lshl_b32 s37, s2, 10
    s_barrier
    s_barrier
    ds_read_b128 v[72:75], v5 offset:0
    s_waitcnt lgkmcnt(0)
    v_add_u32 v76, v72, v73
    v_add_u32 v77, v76, v74
    v_add_u32 v78, v77, v75
    v_mov_b32 v79, v78
    s_nop 1
    v_add_u32_dpp v79, v79, v79 row_shr:1 row_mask:0xf bank_mask:0xf
    s_nop 1
    v_add_u32_dpp v79, v79, v79 row_shr:2 row_mask:0xf bank_mask:0xf
    s_nop 1
    v_add_u32_dpp v79, v79, v79 row_shr:4 row_mask:0xf bank_mask:0xf
    s_nop 1
    v_add_u32_dpp v79, v79, v79 row_shr:8 row_mask:0xf bank_mask:0xf
    s_nop 1
    v_add_u32_dpp v79, v79, v79 row_bcast:15 row_mask:0xa bank_mask:0xf
    s_nop 1
    v_add_u32_dpp v79, v79, v79 row_bcast:31 row_mask:0xc bank_mask:0xf
    v_sub_u32 v80, v79, v78
    v_add_u32 v81, v80, v72
    v_add_u32 v82, v80, v76
    v_add_u32 v83, v80, v77
    ds_write_b128 v5, v[80:83] offset:1024
    v_lshl_or_b32 v72, v81, 16, v80
    v_lshl_or_b32 v73, v82, 16, v81
    v_lshl_or_b32 v74, v83, 16, v82
    v_lshl_or_b32 v75, v79, 16, v83
    s_waitcnt lgkmcnt(0)
    s_barrier
    buffer_store_dwordx4 v[72:75], v5, s[28:31], s37 offen sc1
    s_endpgm
K1_MAIN:
    s_load_dwordx4 s[4:7], s[0:1], 8
    s_load_dwordx2 s[8:9], s[0:1], 24
    s_mul_i32 s3, s2, 3328
    v_lshl_add_u32 v1, v0, 2, s3
    v_lshlrev_b32 v2, 2, v1
    v_lshlrev_b32 v3, 1, v1
    v_mov_b32 v4, 0
    v_lshlrev_b32 v5, 2, v0
    v_cmp_gt_u32 vcc, 0x100, v0
    s_and_saveexec_b64 s[12:13], vcc
    ds_write_b32 v5, v4 offset:0
    s_mov_b64 exec, s[12:13]
    s_waitcnt lgkmcnt(0)
    s_mov_b32 s16, s6
    s_and_b32 s17, s7, 0xffff
    s_mov_b32 s18, 3400000
    s_mov_b32 s19, 0x20000
    buffer_load_dwordx4 v[8:11], v2, s[16:19], 0 offen nt
    s_mov_b32 s20, s4
    s_and_b32 s21, s5, 0xffff
    s_mov_b32 s22, 3400000
    s_mov_b32 s23, 0x20000
    s_mov_b32 s24, s8
    s_and_b32 s25, s9, 0xffff
    s_mov_b32 s26, 1700000
    s_mov_b32 s27, 0x20000
    s_add_u32 s32, s10, 2098176
    s_addc_u32 s33, s11, 0
    s_and_b32 s33, s33, 0xffff
    s_mov_b32 s34, 3407872
    s_mov_b32 s35, 0x20000
    s_add_u32 s52, s10, 262144
    s_addc_u32 s53, s11, 0
    s_and_b32 s53, s53, 0xffff
    s_mov_b32 s54, 1703936
    s_mov_b32 s55, 0x20000
    s_mov_b32 s36, 0xffff0000
    s_mov_b32 s37, 21474
    s_mov_b64 s[12:13], exec
    s_mov_b32 s14, 850000
    v_cmp_gt_u32 s[58:59], s14, v1
    v_mov_b32 v6, 1
    s_barrier
    buffer_load_dwordx4 v[12:15], v2, s[20:23], 0 offen nt
    buffer_load_dwordx2 v[16:17], v3, s[24:27], 0 offen nt
    s_waitcnt vmcnt(2)
    s_mov_b64 exec, s[58:59]
    v_and_b32 v40, 0xff, v8
    v_lshlrev_b32 v40, 2, v40
    ds_add_rtn_u32 v48, v40, v6 offset:0
    v_and_b32 v41, 0xff, v9
    v_lshlrev_b32 v41, 2, v41
    ds_add_rtn_u32 v49, v41, v6 offset:0
    v_and_b32 v42, 0xff, v10
    v_lshlrev_b32 v42, 2, v42
    ds_add_rtn_u32 v50, v42, v6 offset:0
    v_and_b32 v43, 0xff, v11
    v_lshlrev_b32 v43, 2, v43
    ds_add_rtn_u32 v51, v43, v6 offset:0
    s_mov_b64 exec, s[12:13]
    s_waitcnt lgkmcnt(0)
    s_barrier
    s_waitcnt vmcnt(0)
    v_lshl_or_b32 v56, v16, 16, v12
    v_and_or_b32 v57, v16, s36, v13
    v_lshl_or_b32 v58, v17, 16, v14
    v_and_or_b32 v59, v17, s36, v15
    v_mul_u32_u24 v7, s37, v12
    v_lshrrev_b32 v7, 26, v7
    v_and_b32 v7, 12, v7
    v_lshrrev_b32 v64, 8, v8
    v_lshl_or_b32 v64, v64, 4, v7
    v_mul_u32_u24 v7, s37, v13
    v_lshrrev_b32 v7, 26, v7
    v_and_b32 v7, 12, v7
    v_lshrrev_b32 v65, 8, v9
    v_lshl_or_b32 v65, v65, 4, v7
    v_mul_u32_u24 v7, s37, v14
    v_lshrrev_b32 v7, 26, v7
    v_and_b32 v7, 12, v7
    v_lshrrev_b32 v66, 8, v10
    v_lshl_or_b32 v66, v66, 4, v7
    v_mul_u32_u24 v7, s37, v15
    v_lshrrev_b32 v7, 26, v7
    v_and_b32 v7, 12, v7
    v_lshrrev_b32 v67, 8, v11
    v_lshl_or_b32 v67, v67, 4, v7
    s_barrier
    s_mov_b64 exec, s[58:59]
    ds_read_b32 v40, v40 offset:1024
    ds_read_b32 v41, v41 offset:1024
    ds_read_b32 v42, v42 offset:1024
    ds_read_b32 v43, v43 offset:1024
    s_waitcnt lgkmcnt(0)
    v_add_u32 v40, v40, v48
    v_lshlrev_b32 v48, 2, v40
    v_lshlrev_b32 v40, 1, v40
    ds_write_b32 v48, v56 offset:2048
    ds_write_b16 v40, v64 offset:15360
    v_add_u32 v41, v41, v49
    v_lshlrev_b32 v49, 2, v41
    v_lshlrev_b32 v41, 1, v41
    ds_write_b32 v49, v57 offset:2048
    ds_write_b16 v41, v65 offset:15360
    v_add_u32 v42, v42, v50
    v_lshlrev_b32 v50, 2, v42
    v_lshlrev_b32 v42, 1, v42
    ds_write_b32 v50, v58 offset:2048
    ds_write_b16 v42, v66 offset:15360
    v_add_u32 v43, v43, v51
    v_lshlrev_b32 v51, 2, v43
    v_lshlrev_b32 v43, 1, v43
    ds_write_b32 v51, v59 offset:2048
    ds_write_b16 v43, v67 offset:15360
    s_mov_b64 exec, s[12:13]
    v_lshlrev_b32 v5, 4, v0
    s_mul_i32 s37, s2, 13312
    s_mul_i32 s42, s2, 6656
    s_mov_b32 s14, 416
    v_cmp_gt_u32 vcc, s14, v0
    s_waitcnt lgkmcnt(0)
    s_barrier
    ds_read_b128 v[8:11], v5 offset:2048
    s_mov_b64 exec, vcc
    ds_read_b128 v[16:19], v5 offset:15360
    s_mov_b64 exec, s[12:13]
    s_waitcnt lgkmcnt(1)
    buffer_store_dwordx4 v[8:11], v5, s[32:35], s37 offen sc1
    s_waitcnt lgkmcnt(0)
    s_mov_b64 exec, vcc
    s_cbranch_execz K1_FIN
    buffer_store_dwordx4 v[16:19], v5, s[52:55], s42 offen sc1
K1_FIN:
    s_mov_b64 exec, s[12:13]
K1_END:
    s_endpgm
.globl sgc_prop_kernel
.p2align 8
.type sgc_prop_kernel,@function
sgc_prop_kernel:
    s_cmp_ge_u32 s2, 256
    s_cbranch_scc1 K2_END
    s_load_dwordx2 s[6:7], s[0:1], 56
    s_load_dwordx2 s[4:5], s[0:1], 0
    s_load_dwordx4 s[32:35], s[0:1], 32
    s_and_b32 s8, s2, 7
    s_lshl_b32 s8, s8, 5
    s_lshr_b32 s9, s2, 3
    s_add_u32 s8, s8, s9
    v_readfirstlane_b32 s10, v0
    v_and_b32 v1, 63, v0
    v_lshrrev_b32 v52, 4, v1
    s_lshr_b32 s10, s10, 6
    s_lshl_b32 s11, s10, 2
    v_add_u32 v52, s11, v52
    s_lshl_b32 s11, s8, 2
    v_lshl_add_u32 v53, v52, 10, s11
    s_mov_b32 s36, 0
    s_mov_b32 s37, 65536
    s_mov_b32 s38, 131072
    s_mov_b32 s39, 196608
    s_waitcnt lgkmcnt(0)
    s_mov_b32 s16, s6
    s_and_b32 s17, s7, 0xffff
    s_mov_b32 s18, 262144
    s_mov_b32 s19, 0x20000
    buffer_load_dword v56, v53, s[16:19], s36 offen
    buffer_load_dword v57, v53, s[16:19], s37 offen
    buffer_load_dword v58, v53, s[16:19], s38 offen
    buffer_load_dword v59, v53, s[16:19], s39 offen
    s_mov_b32 s14, 6656
    v_mul_u32_u24 v54, s14, v52
    v_and_b32 v55, 15, v1
    s_add_u32 s20, s6, 2098176
    s_addc_u32 s21, s7, 0
    s_and_b32 s21, s21, 0xffff
    s_mov_b32 s22, 3407872
    s_mov_b32 s23, 0x20000
    s_add_u32 s96, s6, 262144
    s_addc_u32 s97, s7, 0
    s_and_b32 s97, s97, 0xffff
    s_mov_b32 s98, 1703936
    s_mov_b32 s99, 0x20000
    s_mov_b32 s40, 0
    s_mov_b32 s41, 851968
    s_mov_b32 s42, 1703936
    s_mov_b32 s43, 2555904
    v_lshlrev_b32 v108, 4, v0
    v_mov_b32 v112, 65535
    v_mov_b32 v113, v112
    v_mov_b32 v114, v112
    v_mov_b32 v115, v112
    v_add_u32 v109, 131072, v108
    ds_write_b128 v109, v[112:115]
    v_mov_b32 v116, 0
    v_mov_b32 v117, 0
    v_mov_b32 v118, 0
    v_mov_b32 v119, 0
    v_cmp_gt_u32 vcc, 256, v0
    s_and_saveexec_b64 s[12:13], vcc
    v_add_u32 v109, 65536, v108
    ds_write_b128 v109, v[112:115]
    s_mov_b64 exec, s[12:13]
    v_cmp_gt_u32 vcc, 32, v0
    s_and_saveexec_b64 s[12:13], vcc
    ds_write_b128 v108, v[116:119]
    s_mov_b64 exec, s[12:13]
    v_cmp_gt_u32 vcc, 320, v0
    s_and_saveexec_b64 s[12:13], vcc
    ds_write_b128 v108, v[116:119] offset:16384
    s_mov_b64 exec, s[12:13]
    s_mov_b32 s24, s4
    s_and_b32 s25, s5, 0xffff
    s_mov_b32 s26, 6400000
    s_mov_b32 s27, 0x20000
    s_add_u32 s28, s6, 12582912
    s_addc_u32 s29, s7, 0
    s_and_b32 s29, s29, 0xffff
    s_mov_b32 s30, 6400000
    s_mov_b32 s31, 0x20000
    s_lshr_b32 s15, s2, 3
    s_mul_i32 s15, s15, 32768
    v_lshlrev_b32 v48, 7, v0
    v_add_u32 v48, s15, v48
    v_lshrrev_b32 v2, 3, v1
    v_lshlrev_b32 v2, 2, v2
    v_and_b32 v3, 7, v1
    v_lshlrev_b32 v3, 4, v3
    v_and_b32 v6, 3, v1
    v_mov_b32 v4, 0x0c0c0c0c
    v_mov_b32 v5, 0x0c0c0c0c
    v_mov_b32 v10, 0x0c0c0302
    v_mov_b32 v11, 0x03020c0c
    v_cmp_eq_u32 vcc, 0, v6
    s_nop 1
    v_cndmask_b32 v4, v4, v10, vcc
    v_cmp_eq_u32 vcc, 1, v6
    s_nop 1
    v_cndmask_b32 v4, v4, v11, vcc
    v_cmp_eq_u32 vcc, 2, v6
    s_nop 1
    v_cndmask_b32 v5, v5, v10, vcc
    v_cmp_eq_u32 vcc, 3, v6
    s_nop 1
    v_cndmask_b32 v5, v5, v11, vcc
    s_mov_b32 s44, 128
    v_mov_b32 v12, 0
    v_mov_b32 v20, 0
    v_mov_b32 v13, 0
    v_mov_b32 v21, 0
    v_mov_b32 v14, 0
    v_mov_b32 v22, 0
    v_mov_b32 v15, 0
    v_mov_b32 v23, 0
    v_mov_b32 v16, 0
    v_mov_b32 v24, 0
    v_mov_b32 v17, 0
    v_mov_b32 v25, 0
    v_mov_b32 v18, 0
    v_mov_b32 v26, 0
    v_mov_b32 v19, 0
    v_mov_b32 v27, 0
    s_mov_b32 s36, 0
    s_mov_b32 s37, 425984
    s_mov_b32 s38, 851968
    s_mov_b32 s39, 1277952
    s_waitcnt vmcnt(0)
    s_mov_b64 s[70:71], 0
    s_mov_b64 s[72:73], exec
    s_mov_b32 s36, 0
    s_mov_b32 s37, 425984
    s_mov_b32 s38, 851968
    s_mov_b32 s39, 1277952
    v_and_b32 v100, 0xffff, v56
    v_lshrrev_b32 v104, 16, v56
    v_add_u32 v100, v100, v55
    v_lshl_add_u32 v60, v100, 1, v54
    v_cmp_lt_u32 s[46:47], v100, v104
    v_add_u32 v41, 16, v100
    s_mov_b64 exec, s[46:47]
    s_cbranch_execz K2_SK_1
    buffer_load_ushort v65, v60, s[96:99], s36 offen
K2_SK_1:
    s_mov_b64 exec, s[72:73]
    v_cmp_lt_u32 s[54:55], v41, v104
    v_and_b32 v101, 0xffff, v57
    v_lshrrev_b32 v105, 16, v57
    v_add_u32 v101, v101, v55
    v_lshl_add_u32 v61, v101, 1, v54
    v_cmp_lt_u32 s[48:49], v101, v105
    v_add_u32 v41, 16, v101
    s_mov_b64 exec, s[48:49]
    s_cbranch_execz K2_SK_2
    buffer_load_ushort v67, v61, s[96:99], s37 offen
K2_SK_2:
    s_mov_b64 exec, s[72:73]
    v_cmp_lt_u32 s[56:57], v41, v105
    v_and_b32 v102, 0xffff, v58
    v_lshrrev_b32 v106, 16, v58
    v_add_u32 v102, v102, v55
    v_lshl_add_u32 v62, v102, 1, v54
    v_cmp_lt_u32 s[50:51], v102, v106
    v_add_u32 v41, 16, v102
    s_mov_b64 exec, s[50:51]
    s_cbranch_execz K2_SK_3
    buffer_load_ushort v69, v62, s[96:99], s38 offen
K2_SK_3:
    s_mov_b64 exec, s[72:73]
    v_cmp_lt_u32 s[58:59], v41, v106
    v_and_b32 v103, 0xffff, v59
    v_lshrrev_b32 v107, 16, v59
    v_add_u32 v103, v103, v55
    v_lshl_add_u32 v63, v103, 1, v54
    v_cmp_lt_u32 s[52:53], v103, v107
    v_add_u32 v41, 16, v103
    s_mov_b64 exec, s[52:53]
    s_cbranch_execz K2_SK_4
    buffer_load_ushort v71, v63, s[96:99], s39 offen
K2_SK_4:
    s_mov_b64 exec, s[72:73]
    v_cmp_lt_u32 s[60:61], v41, v107
    s_mov_b64 exec, s[54:55]
    s_cbranch_execz K2_SK_5
    buffer_load_ushort v73, v60, s[96:99], s36 offen offset:32
K2_SK_5:
    s_mov_b64 exec, s[56:57]
    s_cbranch_execz K2_SK_6
    buffer_load_ushort v75, v61, s[96:99], s37 offen offset:32
K2_SK_6:
    s_mov_b64 exec, s[58:59]
    s_cbranch_execz K2_SK_7
    buffer_load_ushort v77, v62, s[96:99], s38 offen offset:32
K2_SK_7:
    s_mov_b64 exec, s[60:61]
    s_cbranch_execz K2_SK_8
    buffer_load_ushort v79, v63, s[96:99], s39 offen offset:32
K2_SK_8:
    s_mov_b64 exec, s[72:73]
    v_add_u32 v42, 32, v100
    v_cmp_lt_u32 s[62:63], v42, v104
    v_add_u32 v43, 48, v100
    v_cmp_lt_u32 vcc, v43, v104
    v_lshlrev_b32 v44, 1, v60
    s_or_b64 s[70:71], s[70:71], vcc
    v_add_u32 v42, 32, v101
    v_cmp_lt_u32 s[64:65], v42, v105
    v_add_u32 v43, 48, v101
    v_cmp_lt_u32 vcc, v43, v105
    v_lshlrev_b32 v45, 1, v61
    s_or_b64 s[70:71], s[70:71], vcc
    v_add_u32 v42, 32, v102
    v_cmp_lt_u32 s[66:67], v42, v106
    v_add_u32 v43, 48, v102
    v_cmp_lt_u32 vcc, v43, v106
    v_lshlrev_b32 v46, 1, v62
    s_or_b64 s[70:71], s[70:71], vcc
    v_add_u32 v42, 32, v103
    v_cmp_lt_u32 s[68:69], v42, v107
    v_add_u32 v43, 48, v103
    v_cmp_lt_u32 vcc, v43, v107
    v_lshlrev_b32 v47, 1, v63
    s_or_b64 s[70:71], s[70:71], vcc
    s_or_b64 s[74:75], s[62:63], s[64:65]
    s_or_b64 s[74:75], s[74:75], s[66:67]
    s_or_b64 s[74:75], s[74:75], s[68:69]
    s_cselect_b32 s83, 1, 0
    s_cbranch_scc0 K2_NT3A
    s_mov_b64 exec, s[62:63]
    s_cbranch_execz K2_SK_9
    buffer_load_ushort v81, v60, s[96:99], s36 offen offset:64
    buffer_load_dword v80, v44, s[20:23], s40 offen offset:128
K2_SK_9:
    s_mov_b64 exec, s[64:65]
    s_cbranch_execz K2_SK_10
    buffer_load_ushort v83, v61, s[96:99], s37 offen offset:64
    buffer_load_dword v82, v45, s[20:23], s41 offen offset:128
K2_SK_10:
    s_mov_b64 exec, s[66:67]
    s_cbranch_execz K2_SK_11
    buffer_load_ushort v85, v62, s[96:99], s38 offen offset:64
    buffer_load_dword v84, v46, s[20:23], s42 offen offset:128
K2_SK_11:
    s_mov_b64 exec, s[68:69]
    s_cbranch_execz K2_SK_12
    buffer_load_ushort v87, v63, s[96:99], s39 offen offset:64
    buffer_load_dword v86, v47, s[20:23], s43 offen offset:128
K2_SK_12:
    s_mov_b64 exec, s[72:73]
K2_NT3A:
    s_mov_b64 exec, s[72:73]
    v_mov_b32 v40, 1
    v_mov_b32 v11, 32
    s_waitcnt lgkmcnt(0)
    s_barrier
    buffer_load_dword v64, v44, s[20:23], s40 offen
    buffer_load_dword v66, v45, s[20:23], s41 offen
    buffer_load_dword v68, v46, s[20:23], s42 offen
    buffer_load_dword v70, v47, s[20:23], s43 offen
    buffer_load_dword v72, v44, s[20:23], s40 offen offset:64
    buffer_load_dword v74, v45, s[20:23], s41 offen offset:64
    buffer_load_dword v76, v46, s[20:23], s42 offen offset:64
    buffer_load_dword v78, v47, s[20:23], s43 offen offset:64
    s_waitcnt vmcnt(8)
    s_mov_b64 exec, s[46:47]
    s_cbranch_execz K2_SC_13
    ds_add_rtn_u32 v88, v65, v11 offset:16384
K2_SC_13:
    s_mov_b64 exec, s[48:49]
    s_cbranch_execz K2_SC_14
    ds_add_rtn_u32 v89, v67, v11 offset:16384
K2_SC_14:
    s_mov_b64 exec, s[50:51]
    s_cbranch_execz K2_SC_15
    ds_add_rtn_u32 v90, v69, v11 offset:16384
K2_SC_15:
    s_mov_b64 exec, s[52:53]
    s_cbranch_execz K2_SC_16
    ds_add_rtn_u32 v91, v71, v11 offset:16384
K2_SC_16:
    s_mov_b64 exec, s[54:55]
    s_cbranch_execz K2_SC_17
    ds_add_rtn_u32 v92, v73, v11 offset:16384
K2_SC_17:
    s_mov_b64 exec, s[56:57]
    s_cbranch_execz K2_SC_18
    ds_add_rtn_u32 v93, v75, v11 offset:16384
K2_SC_18:
    s_mov_b64 exec, s[58:59]
    s_cbranch_execz K2_SC_19
    ds_add_rtn_u32 v94, v77, v11 offset:16384
K2_SC_19:
    s_mov_b64 exec, s[60:61]
    s_cbranch_execz K2_SC_20
    ds_add_rtn_u32 v95, v79, v11 offset:16384
K2_SC_20:
    s_cmp_eq_u32 s83, 0
    s_cbranch_scc1 K2_NT3B
    s_mov_b64 exec, s[62:63]
    s_cbranch_execz K2_SC_21
    ds_add_rtn_u32 v96, v81, v11 offset:16384
K2_SC_21:
    s_mov_b64 exec, s[64:65]
    s_cbranch_execz K2_SC_22
    ds_add_rtn_u32 v97, v83, v11 offset:16384
K2_SC_22:
    s_mov_b64 exec, s[66:67]
    s_cbranch_execz K2_SC_23
    ds_add_rtn_u32 v98, v85, v11 offset:16384
K2_SC_23:
    s_mov_b64 exec, s[68:69]
    s_cbranch_execz K2_SC_24
    ds_add_rtn_u32 v99, v87, v11 offset:16384
K2_SC_24:
K2_NT3B:
    s_mov_b64 exec, s[72:73]
    s_cmp_eq_u64 s[70:71], 0
    s_cbranch_scc1 K2_NOH
    v_mov_b32 v41, 496
    ds_write_b32 v41, v40
K2_NOH:
    s_waitcnt lgkmcnt(0)
    s_barrier
    s_cmp_ge_u32 s10, 4
    s_cbranch_scc1 K2_NOSORT0
    s_lshl_b32 s12, s10, 6
    v_add_u32 v49, s12, v1
    v_lshlrev_b32 v116, 4, v49
    ds_read_b128 v[100:103], v116 offset:16384
    s_movk_i32 s12, 208
    v_cmp_gt_u32 s[74:75], s12, v49
    v_lshlrev_b32 v117, 2, v1
    s_movk_i32 s76, 0xc0
    s_waitcnt lgkmcnt(0)
    v_add_u32 v47, v100, v101
    v_add3_u32 v47, v47, v102, v103
    v_lshrrev_b32 v47, 5, v47
    v_min_u32 v44, 63, v47
    v_lshlrev_b32 v44, 2, v44
    s_mov_b64 exec, s[74:75]
    ds_add_rtn_u32 v45, v44, v40 offset:20480
    s_mov_b64 exec, s[72:73]
    s_waitcnt lgkmcnt(0)
    s_barrier
    ds_read_b32 v118, v117 offset:20480
    s_waitcnt lgkmcnt(0)
    v_mov_b32 v119, v118
    s_nop 1
    v_add_u32_dpp v119, v119, v119 row_shr:1 row_mask:0xf bank_mask:0xf
    s_nop 1
    v_add_u32_dpp v119, v119, v119 row_shr:2 row_mask:0xf bank_mask:0xf
    s_nop 1
    v_add_u32_dpp v119, v119, v119 row_shr:4 row_mask:0xf bank_mask:0xf
    s_nop 1
    v_add_u32_dpp v119, v119, v119 row_shr:8 row_mask:0xf bank_mask:0xf
    s_nop 1
    v_add_u32_dpp v119, v119, v119 row_bcast:15 row_mask:0xa bank_mask:0xf
    s_nop 1
    v_add_u32_dpp v119, v119, v119 row_bcast:31 row_mask:0xc bank_mask:0xf
    v_sub_u32 v119, v119, v118
    s_nop 0
    ds_bpermute_b32 v46, v44, v119
    s_waitcnt lgkmcnt(0)
    v_add_u32 v45, v45, v46
    v_cmp_le_u32 s[12:13], s76, v45
    v_lshrrev_b32 v46, 4, v45
    v_lshrrev_b32 v118, 3, v45
    v_subrev_u32 v118, 12, v118
    v_mov_b32 v48, 2
    v_cndmask_b32_e64 v46, v46, v118, s[12:13]
    v_cndmask_b32_e64 v48, v48, 1, s[12:13]
    v_lshlrev_b32 v46, 2, v46
    s_mov_b64 exec, s[74:75]
    ds_max_u32 v46, v47 offset:20992
    ds_write_b8 v45, v49 offset:288
    s_mov_b64 exec, s[72:73]
    v_lshlrev_b32 v44, 3, v48
    v_subrev_u32 v44, 1, v44
    v_and_b32 v44, v44, v45
    v_add_u32 v47, v100, v101
    v_add_u32 v45, v47, v102
    s_waitcnt lgkmcnt(0)
    s_barrier
    ds_read_b32 v118, v117 offset:20992
    v_cmp_gt_u32 vcc, 12, v1
    s_waitcnt lgkmcnt(0)
    v_add_u32 v119, 1, v118
    v_lshrrev_b32 v119, 1, v119
    v_cndmask_b32 v118, v119, v118, vcc
    v_lshlrev_b32 v119, 6, v118
    v_mov_b32 v120, v119
    s_nop 1
    v_add_u32_dpp v120, v120, v120 row_shr:1 row_mask:0xf bank_mask:0xf
    s_nop 1
    v_add_u32_dpp v120, v120, v120 row_shr:2 row_mask:0xf bank_mask:0xf
    s_nop 1
    v_add_u32_dpp v120, v120, v120 row_shr:4 row_mask:0xf bank_mask:0xf
    s_nop 1
    v_add_u32_dpp v120, v120, v120 row_shr:8 row_mask:0xf bank_mask:0xf
    s_nop 1
    v_readlane_b32 s76, v120, 11
    v_readlane_b32 s15, v120, 15
    v_sub_u32 v120, v120, v119
    v_add_u32 v121, 131072, v120
    s_sub_u32 s14, 65536, s76
    v_add_u32 v120, s14, v120
    v_cndmask_b32 v120, v120, v121, vcc
    s_nop 0
    ds_bpermute_b32 v46, v46, v120
    s_cmp_lg_u32 s10, 0
    s_cbranch_scc1 K2_NOHDR
    v_cmp_gt_u32 vcc, 16, v1
    s_and_saveexec_b64 s[12:13], vcc
    ds_write_b32 v117, v120 offset:64
    ds_write_b32 v117, v118 offset:0
    s_mov_b64 exec, s[12:13]
    s_sub_u32 s15, s15, s76
    s_cmp_gt_u32 s76, 16384
    s_cbranch_scc1 K2_CAPBAD
    s_cmp_le_u32 s15, 4096
    s_cbranch_scc1 K2_NOHDR
K2_CAPBAD:
    v_mov_b32 v41, 496
    ds_write_b32 v41, v40
K2_NOHDR:
    s_waitcnt lgkmcnt(0)
    v_lshl_add_u32 v103, v44, 2, v46
    v_mad_u32_u24 v101, v100, v48, v103
    v_mov_b32 v100, v103
    v_mad_u32_u24 v102, v47, v48, v100
    v_mad_u32_u24 v103, v45, v48, v100
    s_mov_b64 exec, s[74:75]
    ds_write_b128 v116, v[100:103] offset:21504
    s_mov_b64 exec, s[72:73]
    s_waitcnt vmcnt(0) lgkmcnt(0)
    s_branch K2_NOSORT
K2_NOSORT0:
    s_waitcnt vmcnt(0)
    s_cmp_lt_u32 s10, 12
    s_cbranch_scc1 PFX_25
    s_mov_b32 s15, 98304
    v_subrev_u32 v48, s15, v48
    buffer_load_dword v125, v48, s[24:27], 0 offen
PFX_25:
    s_cmp_lg_u32 s10, 11
    s_cbranch_scc1 TLB_26
    v_lshlrev_b32 v44, 21, v1
    v_add_u32 v44, 1048576, v44
    buffer_load_dword v125, v44, s[24:27], 0 offen
    s_mov_b32 s88, s34
    s_and_b32 s89, s35, 0xffff
    s_mov_b32 s90, 6400000
    s_mov_b32 s91, 0x20000
    buffer_load_dword v125, v44, s[88:91], 0 offen
TLB_26:
    s_barrier
    s_barrier
K2_NOSORT:
    s_barrier
    v_mov_b32 v41, 496
    ds_read_b32 v41, v41
    s_mov_b64 exec, s[46:47]
    s_cbranch_execz K2_SP_27
    ds_read_b32 v100, v65 offset:21504
K2_SP_27:
    s_mov_b64 exec, s[48:49]
    s_cbranch_execz K2_SP_28
    ds_read_b32 v101, v67 offset:21504
K2_SP_28:
    s_mov_b64 exec, s[50:51]
    s_cbranch_execz K2_SP_29
    ds_read_b32 v102, v69 offset:21504
K2_SP_29:
    s_mov_b64 exec, s[52:53]
    s_cbranch_execz K2_SP_30
    ds_read_b32 v103, v71 offset:21504
K2_SP_30:
    s_mov_b64 exec, s[54:55]
    s_cbranch_execz K2_SP_31
    ds_read_b32 v104, v73 offset:21504
K2_SP_31:
    s_mov_b64 exec, s[56:57]
    s_cbranch_execz K2_SP_32
    ds_read_b32 v105, v75 offset:21504
K2_SP_32:
    s_mov_b64 exec, s[58:59]
    s_cbranch_execz K2_SP_33
    ds_read_b32 v106, v77 offset:21504
K2_SP_33:
    s_mov_b64 exec, s[60:61]
    s_cbranch_execz K2_SP_34
    ds_read_b32 v107, v79 offset:21504
K2_SP_34:
    s_cmp_eq_u32 s83, 0
    s_cbranch_scc1 K2_NT3C
    s_mov_b64 exec, s[62:63]
    s_cbranch_execz K2_SP_35
    ds_read_b32 v108, v81 offset:21504
K2_SP_35:
    s_mov_b64 exec, s[64:65]
    s_cbranch_execz K2_SP_36
    ds_read_b32 v109, v83 offset:21504
K2_SP_36:
    s_mov_b64 exec, s[66:67]
    s_cbranch_execz K2_SP_37
    ds_read_b32 v110, v85 offset:21504
K2_SP_37:
    s_mov_b64 exec, s[68:69]
    s_cbranch_execz K2_SP_38
    ds_read_b32 v111, v87 offset:21504
K2_SP_38:
K2_NT3C:
    s_mov_b64 exec, s[72:73]
    s_lshl_b32 s45, s10, 2
    v_mov_b32 v10, s45
    ds_read_b32 v7, v10 offset:0
    ds_read_b32 v6, v10 offset:64
    v_lshrrev_b32 v9, 2, v2
    s_lshl_b32 s45, s10, 4
    s_lshl_b32 s14, s10, 3
    s_add_u32 s14, s14, 96
    s_cmp_lt_u32 s10, 12
    s_cselect_b32 s45, s45, s14
    v_add_u32 v8, s45, v9
    v_add_u32 v9, 8, v8
    ds_read_u8 v8, v8 offset:288
    ds_read_u8 v9, v9 offset:288
    s_waitcnt lgkmcnt(0)
    v_readfirstlane_b32 s77, v41
    v_readfirstlane_b32 s78, v7
    v_add_u32 v6, v6, v2
    s_cmp_lg_u32 s77, 0
    s_cbranch_scc1 K2_NOPLACE
    s_mov_b64 exec, s[46:47]
    s_cbranch_execz K2_SW_39
    v_mad_u32_u16 v100, v88, v100, v100 op_sel:[0,1,0,0]
    ds_write_b32 v100, v64
K2_SW_39:
    s_mov_b64 exec, s[48:49]
    s_cbranch_execz K2_SW_40
    v_mad_u32_u16 v101, v89, v101, v101 op_sel:[0,1,0,0]
    ds_write_b32 v101, v66
K2_SW_40:
    s_mov_b64 exec, s[50:51]
    s_cbranch_execz K2_SW_41
    v_mad_u32_u16 v102, v90, v102, v102 op_sel:[0,1,0,0]
    ds_write_b32 v102, v68
K2_SW_41:
    s_mov_b64 exec, s[52:53]
    s_cbranch_execz K2_SW_42
    v_mad_u32_u16 v103, v91, v103, v103 op_sel:[0,1,0,0]
    ds_write_b32 v103, v70
K2_SW_42:
    s_mov_b64 exec, s[54:55]
    s_cbranch_execz K2_SW_43
    v_mad_u32_u16 v104, v92, v104, v104 op_sel:[0,1,0,0]
    ds_write_b32 v104, v72
K2_SW_43:
    s_mov_b64 exec, s[56:57]
    s_cbranch_execz K2_SW_44
    v_mad_u32_u16 v105, v93, v105, v105 op_sel:[0,1,0,0]
    ds_write_b32 v105, v74
K2_SW_44:
    s_mov_b64 exec, s[58:59]
    s_cbranch_execz K2_SW_45
    v_mad_u32_u16 v106, v94, v106, v106 op_sel:[0,1,0,0]
    ds_write_b32 v106, v76
K2_SW_45:
    s_mov_b64 exec, s[60:61]
    s_cbranch_execz K2_SW_46
    v_mad_u32_u16 v107, v95, v107, v107 op_sel:[0,1,0,0]
    ds_write_b32 v107, v78
K2_SW_46:
    s_cmp_eq_u32 s83, 0
    s_cbranch_scc1 K2_NT3D
    s_mov_b64 exec, s[62:63]
    s_cbranch_execz K2_SW_47
    v_mad_u32_u16 v108, v96, v108, v108 op_sel:[0,1,0,0]
    ds_write_b32 v108, v80
K2_SW_47:
    s_mov_b64 exec, s[64:65]
    s_cbranch_execz K2_SW_48
    v_mad_u32_u16 v109, v97, v109, v109 op_sel:[0,1,0,0]
    ds_write_b32 v109, v82
K2_SW_48:
    s_mov_b64 exec, s[66:67]
    s_cbranch_execz K2_SW_49
    v_mad_u32_u16 v110, v98, v110, v110 op_sel:[0,1,0,0]
    ds_write_b32 v110, v84
K2_SW_49:
    s_mov_b64 exec, s[68:69]
    s_cbranch_execz K2_SW_50
    v_mad_u32_u16 v111, v99, v111, v111 op_sel:[0,1,0,0]
    ds_write_b32 v111, v86
K2_SW_50:
K2_NT3D:
    s_mov_b64 exec, s[72:73]
K2_NOPLACE:
    s_waitcnt lgkmcnt(0)
    s_barrier
    s_mov_b32 s47, 0
    s_cmp_lt_u32 s10, 14
    s_cbranch_scc1 K2_KEEP
    s_cmp_eq_u32 s77, 0
    s_cbranch_scc1 K2_END
K2_KEEP:
    s_mov_b32 s16, s32
    s_and_b32 s17, s33, 0xffff
    s_mov_b32 s18, 8192
    s_mov_b32 s19, 0x20000
    v_lshlrev_b32 v110, 4, v0
    buffer_load_dwordx4 v[112:115], v110, s[16:19], 0 offen
K2_PHASE:
    s_cmp_eq_u32 s77, 0
    s_cbranch_scc1 K2_FAST
    s_cmp_eq_u32 s47, 0
    s_cbranch_scc1 RG_51
    s_cmp_lg_u32 s10, 0
    s_cbranch_scc1 RH_52
    s_call_b64 s[84:85], GPOLL
RH_52:
    s_barrier
RG_51:
    v_mov_b32 v40, 0
    v_mov_b32 v41, 0
    v_mov_b32 v42, 0
    v_mov_b32 v43, 0
    v_lshlrev_b32 v44, 4, v0
    v_add_u32 v44, 62464, v44
    ds_write_b128 v44, v[40:43] offset:0
    ds_write_b128 v44, v[40:43] offset:16384
    ds_write_b128 v44, v[40:43] offset:32768
    v_cmp_gt_u32 vcc, 256, v0
    s_and_saveexec_b64 s[60:61], vcc
    ds_write_b128 v44, v[40:43] offset:49152
    s_mov_b64 exec, s[60:61]
    s_waitcnt lgkmcnt(0)
    s_barrier
    s_mov_b32 s62, s10
    v_lshrrev_b32 v45, 3, v1
    s_lshl_b32 s63, s8, 2
K2H_HC:
    s_lshl_b32 s64, s62, 10
    s_add_u32 s64, s64, s63
    s_add_u32 s66, s6, s64
    s_addc_u32 s67, s7, 0
    s_load_dword s68, s[66:67], 0
    s_mul_i32 s69, s62, 13312
    s_mul_i32 s65, s62, 6656
    s_waitcnt lgkmcnt(0)
    s_and_b32 s70, s68, 0xffff
    s_lshr_b32 s71, s68, 16
K2H_HI:
    s_cmp_ge_u32 s70, s71
    s_cbranch_scc1 K2H_HN
    v_add_u32 v46, s70, v45
    v_cmp_gt_u32 vcc, s71, v46
    s_and_saveexec_b64 s[60:61], vcc
    v_lshlrev_b32 v47, 2, v46
    buffer_load_dword v48, v47, s[20:23], s69 offen
    v_lshlrev_b32 v47, 1, v46
    buffer_load_ushort v49, v47, s[96:99], s65 offen
    s_waitcnt vmcnt(0)
    v_and_b32 v50, 0xffff, v48
    v_lshlrev_b32 v50, 7, v50
    v_add_u32 v50, v50, v3
    buffer_load_dwordx4 v[52:55], v50, s[24:27], 0 offen sc1
    v_and_b32 v51, 0xffff0000, v48
    v_lshrrev_b32 v56, 4, v49
    v_lshlrev_b32 v56, 8, v56
    v_lshlrev_b32 v57, 1, v3
    v_add_u32 v56, v56, v57
    v_add_u32 v56, 62464, v56
    s_waitcnt vmcnt(0)
    v_lshlrev_b32 v58, 16, v52
    v_and_b32 v59, 0xffff0000, v52
    v_mul_f32 v58, v58, v51
    v_mul_f32 v59, v59, v51
    ds_add_f32 v56, v58 offset:0
    ds_add_f32 v56, v59 offset:4
    v_lshlrev_b32 v58, 16, v53
    v_and_b32 v59, 0xffff0000, v53
    v_mul_f32 v58, v58, v51
    v_mul_f32 v59, v59, v51
    ds_add_f32 v56, v58 offset:8
    ds_add_f32 v56, v59 offset:12
    v_lshlrev_b32 v58, 16, v54
    v_and_b32 v59, 0xffff0000, v54
    v_mul_f32 v58, v58, v51
    v_mul_f32 v59, v59, v51
    ds_add_f32 v56, v58 offset:16
    ds_add_f32 v56, v59 offset:20
    v_lshlrev_b32 v58, 16, v55
    v_and_b32 v59, 0xffff0000, v55
    v_mul_f32 v58, v58, v51
    v_mul_f32 v59, v59, v51
    ds_add_f32 v56, v58 offset:24
    ds_add_f32 v56, v59 offset:28
    s_mov_b64 exec, s[60:61]
    s_add_u32 s70, s70, 8
    s_branch K2H_HI
K2H_HN:
    s_add_u32 s62, s62, 16
    s_cmp_lt_u32 s62, 256
    s_cbranch_scc1 K2H_HC
    s_waitcnt lgkmcnt(0)
    s_barrier
    v_lshrrev_b32 v9, 2, v2
    s_lshl_b32 s45, s10, 4
    v_add_u32 v8, s45, v9
    v_add_u32 v9, 8, v8
    v_lshlrev_b32 v10, 8, v8
    v_lshlrev_b32 v11, 1, v3
    v_add_u32 v10, v10, v11
    v_add_u32 v10, 62464, v10
    ds_read_b128 v[12:15], v10
    ds_read_b128 v[16:19], v10 offset:16
    v_lshlrev_b32 v10, 8, v9
    v_lshlrev_b32 v11, 1, v3
    v_add_u32 v10, v10, v11
    v_add_u32 v10, 62464, v10
    ds_read_b128 v[20:23], v10
    ds_read_b128 v[24:27], v10 offset:16
    s_waitcnt lgkmcnt(0)
    s_cmp_lt_u32 s10, 13
    s_cbranch_scc1 K2_DONE
    s_cmp_lg_u32 s47, 0
    s_cbranch_scc1 K2_END
    v_mov_b32 v8, 0xff
    v_mov_b32 v9, 0xff
    s_branch K2_DONE
K2_FAST:
    s_cmp_eq_u32 s47, 0
    s_cbranch_scc1 K2_HOPIN0
    s_lshl_b32 s45, s10, 2
    v_mov_b32 v10, s45
    v_mov_b32 v41, 496
    ds_read_b32 v41, v41
    ds_read_b32 v11, v10 offset:0
    ds_read_b32 v6, v10 offset:64
    v_lshrrev_b32 v9, 2, v2
    s_lshl_b32 s45, s10, 4
    s_lshl_b32 s46, s10, 3
    s_add_u32 s46, s46, 96
    s_cmp_lt_u32 s10, 12
    s_cselect_b32 s45, s45, s46
    v_add_u32 v8, s45, v9
    v_add_u32 v9, 8, v8
    ds_read_u8 v8, v8 offset:288
    ds_read_u8 v9, v9 offset:288
    s_waitcnt lgkmcnt(0)
    v_readfirstlane_b32 s77, v41
    v_readfirstlane_b32 s78, v11
    v_add_u32 v6, v6, v2
    s_cmp_lt_u32 s10, 12
    s_cbranch_scc1 HH_53
    v_mov_b32 v9, 0xff
HH_53:
    s_branch K2_HOPIN
K2_HOPIN0:
    s_cmp_lt_u32 s10, 12
    s_cbranch_scc1 K2_HOPIN
    v_mov_b32 v9, 0xff
K2_HOPIN:
    s_min_u32 s78, s78, 0x100
    s_mov_b32 s81, s78
    s_mov_b32 s80, 0
    s_mov_b32 s79, 8
    s_mov_b32 s76, 6
    ds_read2_b32 v[40:41], v6 offset0:0 offset1:8
    ds_read2_b32 v[48:49], v6 offset0:16 offset1:24
    ds_read2_b32 v[56:57], v6 offset0:32 offset1:40
    ds_read2_b32 v[64:65], v6 offset0:48 offset1:56
    ds_read2_b32 v[32:33], v6 offset0:0 offset1:8
    v_add_u32 v7, 256, v6
    s_waitcnt lgkmcnt(0)
    ds_read2_b32 v[36:37], v7 offset0:0 offset1:8
    s_cmp_eq_u32 s47, 0
    s_cbranch_scc1 RG_54
    s_cmp_lg_u32 s10, 0
    s_cbranch_scc1 RH_55
    s_call_b64 s[84:85], GPOLL
RH_55:
    s_barrier
RG_54:
    s_cmp_eq_u32 s78, 0
    s_cbranch_scc1 K2S_FIN
    v_mad_u32_u16 v10, v40, s44, v3
    v_mad_u32_u16 v11, v41, s44, v3
    buffer_load_dwordx4 v[40:43], v10, s[24:27], 0 offen sc1
    buffer_load_dwordx4 v[44:47], v11, s[24:27], 0 offen sc1
    s_cmp_le_u32 s78, 1
    s_cbranch_scc1 K2S_DR0
    s_add_u32 s80, s80, s79
    s_cmp_lt_i32 s80, s78
    s_cbranch_scc1 K2S_PC_56
    s_call_b64 s[84:85], K2S_BS
K2S_PC_56:
    v_mad_u32_u16 v10, v48, s44, v3
    v_mad_u32_u16 v11, v49, s44, v3
    buffer_load_dwordx4 v[48:51], v10, s[24:27], 0 offen sc1
    buffer_load_dwordx4 v[52:55], v11, s[24:27], 0 offen sc1
    s_cmp_le_u32 s78, 2
    s_cbranch_scc1 K2S_DR0
    s_add_u32 s80, s80, s79
    s_cmp_lt_i32 s80, s78
    s_cbranch_scc1 K2S_PC_57
    s_call_b64 s[84:85], K2S_BS
K2S_PC_57:
    v_mad_u32_u16 v10, v56, s44, v3
    v_mad_u32_u16 v11, v57, s44, v3
    buffer_load_dwordx4 v[56:59], v10, s[24:27], 0 offen sc1
    buffer_load_dwordx4 v[60:63], v11, s[24:27], 0 offen sc1
    s_cmp_le_u32 s78, 3
    s_cbranch_scc1 K2S_DR0
    s_add_u32 s80, s80, s79
    s_cmp_lt_i32 s80, s78
    s_cbranch_scc1 K2S_PC_58
    s_call_b64 s[84:85], K2S_BS
K2S_PC_58:
    v_mad_u32_u16 v10, v64, s44, v3
    v_mad_u32_u16 v11, v65, s44, v3
    buffer_load_dwordx4 v[64:67], v10, s[24:27], 0 offen sc1
    buffer_load_dwordx4 v[68:71], v11, s[24:27], 0 offen sc1
    s_sub_u32 s82, s78, 4
    s_mov_b32 s81, 4
    s_cmp_eq_u32 s82, 0
    s_cbranch_scc1 K2S_DR0
K2S_MAIN:
    s_waitcnt lgkmcnt(0)
    ds_read2_b32 v[34:35], v6 offset0:16 offset1:24
    ds_read2_b32 v[38:39], v7 offset0:16 offset1:24
    v_perm_b32 v28, v32, v32, v4
    v_perm_b32 v29, v32, v32, v5
    v_perm_b32 v30, v33, v33, v4
    v_perm_b32 v31, v33, v33, v5
    v_mad_u32_u16 v10, v36, s44, v3
    v_mad_u32_u16 v11, v37, s44, v3
    s_waitcnt vmcnt(6)
    v_mfma_f32_4x4x4_16b_bf16 v[12:15], v[28:29], v[40:41], v[12:15]
    v_mfma_f32_4x4x4_16b_bf16 v[16:19], v[28:29], v[42:43], v[16:19]
    v_mfma_f32_4x4x4_16b_bf16 v[20:23], v[30:31], v[44:45], v[20:23]
    v_mfma_f32_4x4x4_16b_bf16 v[24:27], v[30:31], v[46:47], v[24:27]
    s_add_u32 s80, s80, s79
    s_cmp_lt_i32 s80, s78
    s_cbranch_scc1 K2S_PC_59
    s_call_b64 s[84:85], K2S_BS
K2S_PC_59:
    buffer_load_dwordx4 v[40:43], v10, s[24:27], 0 offen sc1
    buffer_load_dwordx4 v[44:47], v11, s[24:27], 0 offen sc1
    s_sub_u32 s82, s82, 1
    s_cmp_eq_u32 s82, 0
    s_cbranch_scc1 K2S_DR1
    s_waitcnt lgkmcnt(0)
    ds_read2_b32 v[32:33], v6 offset0:32 offset1:40
    ds_read2_b32 v[36:37], v7 offset0:32 offset1:40
    v_perm_b32 v28, v34, v34, v4
    v_perm_b32 v29, v34, v34, v5
    v_perm_b32 v30, v35, v35, v4
    v_perm_b32 v31, v35, v35, v5
    v_mad_u32_u16 v10, v38, s44, v3
    v_mad_u32_u16 v11, v39, s44, v3
    s_waitcnt vmcnt(6)
    v_mfma_f32_4x4x4_16b_bf16 v[12:15], v[28:29], v[48:49], v[12:15]
    v_mfma_f32_4x4x4_16b_bf16 v[16:19], v[28:29], v[50:51], v[16:19]
    v_mfma_f32_4x4x4_16b_bf16 v[20:23], v[30:31], v[52:53], v[20:23]
    v_mfma_f32_4x4x4_16b_bf16 v[24:27], v[30:31], v[54:55], v[24:27]
    s_add_u32 s80, s80, s79
    s_cmp_lt_i32 s80, s78
    s_cbranch_scc1 K2S_PC_60
    s_call_b64 s[84:85], K2S_BS
K2S_PC_60:
    buffer_load_dwordx4 v[48:51], v10, s[24:27], 0 offen sc1
    buffer_load_dwordx4 v[52:55], v11, s[24:27], 0 offen sc1
    s_sub_u32 s82, s82, 1
    s_cmp_eq_u32 s82, 0
    s_cbranch_scc1 K2S_DR2
    s_waitcnt lgkmcnt(0)
    ds_read2_b32 v[34:35], v6 offset0:48 offset1:56
    ds_read2_b32 v[38:39], v7 offset0:48 offset1:56
    v_perm_b32 v28, v32, v32, v4
    v_perm_b32 v29, v32, v32, v5
    v_perm_b32 v30, v33, v33, v4
    v_perm_b32 v31, v33, v33, v5
    v_mad_u32_u16 v10, v36, s44, v3
    v_mad_u32_u16 v11, v37, s44, v3
    s_waitcnt vmcnt(6)
    v_mfma_f32_4x4x4_16b_bf16 v[12:15], v[28:29], v[56:57], v[12:15]
    v_mfma_f32_4x4x4_16b_bf16 v[16:19], v[28:29], v[58:59], v[16:19]
    v_mfma_f32_4x4x4_16b_bf16 v[20:23], v[30:31], v[60:61], v[20:23]
    v_mfma_f32_4x4x4_16b_bf16 v[24:27], v[30:31], v[62:63], v[24:27]
    s_add_u32 s80, s80, s79
    s_cmp_lt_i32 s80, s78
    s_cbranch_scc1 K2S_PC_61
    s_call_b64 s[84:85], K2S_BS
K2S_PC_61:
    buffer_load_dwordx4 v[56:59], v10, s[24:27], 0 offen sc1
    buffer_load_dwordx4 v[60:63], v11, s[24:27], 0 offen sc1
    s_sub_u32 s82, s82, 1
    s_cmp_eq_u32 s82, 0
    s_cbranch_scc1 K2S_DR3
    s_waitcnt lgkmcnt(0)
    ds_read2_b32 v[32:33], v6 offset0:64 offset1:72
    ds_read2_b32 v[36:37], v7 offset0:64 offset1:72
    v_perm_b32 v28, v34, v34, v4
    v_perm_b32 v29, v34, v34, v5
    v_perm_b32 v30, v35, v35, v4
    v_perm_b32 v31, v35, v35, v5
    v_mad_u32_u16 v10, v38, s44, v3
    v_mad_u32_u16 v11, v39, s44, v3
    s_waitcnt vmcnt(6)
    v_mfma_f32_4x4x4_16b_bf16 v[12:15], v[28:29], v[64:65], v[12:15]
    v_mfma_f32_4x4x4_16b_bf16 v[16:19], v[28:29], v[66:67], v[16:19]
    v_mfma_f32_4x4x4_16b_bf16 v[20:23], v[30:31], v[68:69], v[20:23]
    v_mfma_f32_4x4x4_16b_bf16 v[24:27], v[30:31], v[70:71], v[24:27]
    s_add_u32 s80, s80, s79
    s_cmp_lt_i32 s80, s78
    s_cbranch_scc1 K2S_PC_62
    s_call_b64 s[84:85], K2S_BS
K2S_PC_62:
    buffer_load_dwordx4 v[64:67], v10, s[24:27], 0 offen sc1
    buffer_load_dwordx4 v[68:71], v11, s[24:27], 0 offen sc1
    v_add_u32 v6, 256, v6
    v_add_u32 v7, 256, v7
    s_sub_u32 s82, s82, 1
    s_cmp_eq_u32 s82, 0
    s_cbranch_scc0 K2S_MAIN
K2S_DR0:
    s_cmp_eq_u32 s76, 0
    s_cbranch_scc1 K2S_DX_63
    s_call_b64 s[84:85], K2S_BF
K2S_DX_63:
    s_waitcnt lgkmcnt(0)
    ds_read2_b32 v[34:35], v6 offset0:16 offset1:24
    v_perm_b32 v28, v32, v32, v4
    v_perm_b32 v29, v32, v32, v5
    v_perm_b32 v30, v33, v33, v4
    v_perm_b32 v31, v33, v33, v5
    s_waitcnt vmcnt(0)
    s_sub_u32 s81, s81, 1
    v_mfma_f32_4x4x4_16b_bf16 v[12:15], v[28:29], v[40:41], v[12:15]
    v_mfma_f32_4x4x4_16b_bf16 v[16:19], v[28:29], v[42:43], v[16:19]
    v_mfma_f32_4x4x4_16b_bf16 v[20:23], v[30:31], v[44:45], v[20:23]
    v_mfma_f32_4x4x4_16b_bf16 v[24:27], v[30:31], v[46:47], v[24:27]
    s_cmp_eq_u32 s81, 0
    s_cbranch_scc1 K2S_FIN
K2S_DR1:
    s_cmp_eq_u32 s76, 0
    s_cbranch_scc1 K2S_DX_64
    s_call_b64 s[84:85], K2S_BF
K2S_DX_64:
    s_waitcnt lgkmcnt(0)
    ds_read2_b32 v[32:33], v6 offset0:32 offset1:40
    v_perm_b32 v28, v34, v34, v4
    v_perm_b32 v29, v34, v34, v5
    v_perm_b32 v30, v35, v35, v4
    v_perm_b32 v31, v35, v35, v5
    s_waitcnt vmcnt(0)
    s_sub_u32 s81, s81, 1
    v_mfma_f32_4x4x4_16b_bf16 v[12:15], v[28:29], v[48:49], v[12:15]
    v_mfma_f32_4x4x4_16b_bf16 v[16:19], v[28:29], v[50:51], v[16:19]
    v_mfma_f32_4x4x4_16b_bf16 v[20:23], v[30:31], v[52:53], v[20:23]
    v_mfma_f32_4x4x4_16b_bf16 v[24:27], v[30:31], v[54:55], v[24:27]
    s_cmp_eq_u32 s81, 0
    s_cbranch_scc1 K2S_FIN
K2S_DR2:
    s_cmp_eq_u32 s76, 0
    s_cbranch_scc1 K2S_DX_65
    s_call_b64 s[84:85], K2S_BF
K2S_DX_65:
    s_waitcnt lgkmcnt(0)
    ds_read2_b32 v[34:35], v6 offset0:48 offset1:56
    v_perm_b32 v28, v32, v32, v4
    v_perm_b32 v29, v32, v32, v5
    v_perm_b32 v30, v33, v33, v4
    v_perm_b32 v31, v33, v33, v5
    s_waitcnt vmcnt(0)
    s_sub_u32 s81, s81, 1
    v_mfma_f32_4x4x4_16b_bf16 v[12:15], v[28:29], v[56:57], v[12:15]
    v_mfma_f32_4x4x4_16b_bf16 v[16:19], v[28:29], v[58:59], v[16:19]
    v_mfma_f32_4x4x4_16b_bf16 v[20:23], v[30:31], v[60:61], v[20:23]
    v_mfma_f32_4x4x4_16b_bf16 v[24:27], v[30:31], v[62:63], v[24:27]
    s_cmp_eq_u32 s81, 0
    s_cbranch_scc1 K2S_FIN
K2S_DR3:
    s_cmp_eq_u32 s76, 0
    s_cbranch_scc1 K2S_DX_66
    s_call_b64 s[84:85], K2S_BF
K2S_DX_66:
    s_waitcnt lgkmcnt(0)
    ds_read2_b32 v[32:33], v6 offset0:64 offset1:72
    v_perm_b32 v28, v34, v34, v4
    v_perm_b32 v29, v34, v34, v5
    v_perm_b32 v30, v35, v35, v4
    v_perm_b32 v31, v35, v35, v5
    s_waitcnt vmcnt(0)
    s_sub_u32 s81, s81, 1
    v_mfma_f32_4x4x4_16b_bf16 v[12:15], v[28:29], v[64:65], v[12:15]
    v_mfma_f32_4x4x4_16b_bf16 v[16:19], v[28:29], v[66:67], v[16:19]
    v_mfma_f32_4x4x4_16b_bf16 v[20:23], v[30:31], v[68:69], v[20:23]
    v_mfma_f32_4x4x4_16b_bf16 v[24:27], v[30:31], v[70:71], v[24:27]
    s_cmp_eq_u32 s81, 0
    s_cbranch_scc1 K2S_FIN
    s_waitcnt lgkmcnt(0)
    ds_read2_b32 v[34:35], v6 offset0:80 offset1:88
    v_perm_b32 v28, v32, v32, v4
    v_perm_b32 v29, v32, v32, v5
    v_perm_b32 v30, v33, v33, v4
    v_perm_b32 v31, v33, v33, v5
    s_waitcnt vmcnt(0)
    s_sub_u32 s81, s81, 1
    v_mfma_f32_4x4x4_16b_bf16 v[12:15], v[28:29], v[40:41], v[12:15]
    v_mfma_f32_4x4x4_16b_bf16 v[16:19], v[28:29], v[42:43], v[16:19]
    v_mfma_f32_4x4x4_16b_bf16 v[20:23], v[30:31], v[44:45], v[20:23]
    v_mfma_f32_4x4x4_16b_bf16 v[24:27], v[30:31], v[46:47], v[24:27]
    s_cmp_eq_u32 s81, 0
    s_cbranch_scc1 K2S_FIN
    s_waitcnt lgkmcnt(0)
    ds_read2_b32 v[32:33], v6 offset0:96 offset1:104
    v_perm_b32 v28, v34, v34, v4
    v_perm_b32 v29, v34, v34, v5
    v_perm_b32 v30, v35, v35, v4
    v_perm_b32 v31, v35, v35, v5
    s_waitcnt vmcnt(0)
    s_sub_u32 s81, s81, 1
    v_mfma_f32_4x4x4_16b_bf16 v[12:15], v[28:29], v[48:49], v[12:15]
    v_mfma_f32_4x4x4_16b_bf16 v[16:19], v[28:29], v[50:51], v[16:19]
    v_mfma_f32_4x4x4_16b_bf16 v[20:23], v[30:31], v[52:53], v[20:23]
    v_mfma_f32_4x4x4_16b_bf16 v[24:27], v[30:31], v[54:55], v[24:27]
    s_cmp_eq_u32 s81, 0
    s_cbranch_scc1 K2S_FIN
    s_waitcnt lgkmcnt(0)
    v_perm_b32 v28, v32, v32, v4
    v_perm_b32 v29, v32, v32, v5
    v_perm_b32 v30, v33, v33, v4
    v_perm_b32 v31, v33, v33, v5
    s_waitcnt vmcnt(0)
    s_sub_u32 s81, s81, 1
    v_mfma_f32_4x4x4_16b_bf16 v[12:15], v[28:29], v[56:57], v[12:15]
    v_mfma_f32_4x4x4_16b_bf16 v[16:19], v[28:29], v[58:59], v[16:19]
    v_mfma_f32_4x4x4_16b_bf16 v[20:23], v[30:31], v[60:61], v[20:23]
    v_mfma_f32_4x4x4_16b_bf16 v[24:27], v[30:31], v[62:63], v[24:27]
K2S_FIN:
    s_cmp_eq_u32 s76, 0
    s_cbranch_scc1 K2S_DY_67
    s_call_b64 s[84:85], K2S_BF
K2S_DY_67:
    s_nop 4
    s_cmp_lt_u32 s10, 12
    s_cbranch_scc1 K2S_SF_68
    v_add_f32 v12, v12, v20
    v_add_f32 v13, v13, v21
    v_add_f32 v14, v14, v22
    v_add_f32 v15, v15, v23
    v_add_f32 v16, v16, v24
    v_add_f32 v17, v17, v25
    v_add_f32 v18, v18, v26
    v_add_f32 v19, v19, v27
K2S_SF_68:
K2_DONE:
    s_cmp_lg_u32 s47, 0
    s_cbranch_scc1 K2_GEMM
    s_lshl_b32 s45, s8, 7
    v_cvt_pk_bf16_f32 v28, v12, v13
    v_cvt_pk_bf16_f32 v29, v14, v15
    v_cvt_pk_bf16_f32 v30, v16, v17
    v_cvt_pk_bf16_f32 v31, v18, v19
    v_lshlrev_b32 v10, 15, v8
    v_add3_u32 v10, v10, s45, v3
    buffer_store_dwordx4 v[28:31], v10, s[28:31], 0 offen sc1
    v_cvt_pk_bf16_f32 v32, v20, v21
    v_cvt_pk_bf16_f32 v33, v22, v23
    v_cvt_pk_bf16_f32 v34, v24, v25
    v_cvt_pk_bf16_f32 v35, v26, v27
    v_lshlrev_b32 v11, 15, v9
    v_add3_u32 v11, v11, s45, v3
    buffer_store_dwordx4 v[32:35], v11, s[28:31], 0 offen sc1
    v_cmp_gt_u32 vcc, 0x200, v0
    s_and_saveexec_b64 s[72:73], vcc
    ds_write_b128 v110, v[112:115] offset:25600
    s_mov_b64 exec, s[72:73]
    s_lshl_b32 s83, s10, 11
    s_add_u32 s83, s83, 33792
    v_lshlrev_b32 v60, 2, v2
    v_xor_b32 v61, v60, v3
    v_lshlrev_b32 v60, 3, v60
    v_add3_u32 v104, v60, v61, s83
    v_and_b32 v60, 15, v1
    v_lshrrev_b32 v109, 4, v1
    v_and_b32 v61, 7, v60
    v_lshlrev_b32 v108, 5, v61
    v_xor_b32 v62, v109, v61
    v_lshlrev_b32 v62, 4, v62
    v_lshlrev_b32 v63, 7, v60
    v_add3_u32 v105, v63, s83, v62
    v_xor_b32 v62, 64, v62
    v_add3_u32 v106, v63, s83, v62
    v_lshrrev_b32 v62, 2, v60
    v_lshl_add_u32 v62, v109, 3, v62
    v_lshlrev_b32 v62, 7, v62
    v_and_b32 v63, 3, v1
    v_lshl_add_u32 v107, v63, 4, v62
    v_cmp_gt_u32 s[74:75], 8, v60
    v_lshlrev_b32 v109, 4, v109
    v_mov_b32 v12, 0
    v_mov_b32 v20, 0
    v_mov_b32 v13, 0
    v_mov_b32 v21, 0
    v_mov_b32 v14, 0
    v_mov_b32 v22, 0
    v_mov_b32 v15, 0
    v_mov_b32 v23, 0
    v_mov_b32 v16, 0
    v_mov_b32 v24, 0
    v_mov_b32 v17, 0
    v_mov_b32 v25, 0
    v_mov_b32 v18, 0
    v_mov_b32 v26, 0
    v_mov_b32 v19, 0
    v_mov_b32 v27, 0
    s_add_u32 s24, s6, 12582912
    s_addc_u32 s25, s7, 0
    s_and_b32 s25, s25, 0xffff
    s_mov_b32 s26, 6400000
    s_mov_b32 s27, 0x20000
    s_waitcnt vmcnt(0) lgkmcnt(0)
    s_mov_b32 s28, s34
    s_and_b32 s29, s35, 0xffff
    s_mov_b32 s30, 6400000
    s_mov_b32 s31, 0x20000
    s_barrier
    s_cmp_lg_u32 s10, 0
    s_cbranch_scc1 K2_NOPOLL
    s_and_b32 s45, s2, 3
    s_lshl_b32 s45, s45, 7
    s_add_u32 s45, s45, 1966080
    v_lshlrev_b32 v116, 9, v1
    v_add_u32 v116, s45, v116
    v_mov_b32 v117, 1
    s_mov_b64 s[72:73], exec
    s_mov_b64 exec, 0xffff
    global_atomic_add v116, v117, s[6:7] sc1
    s_mov_b64 exec, s[72:73]
K2_NOPOLL:
    ds_read_b64_tr_b16 v[72:73], v107 offset:25600
    ds_read_b64_tr_b16 v[74:75], v107 offset:26112
    ds_read_b64_tr_b16 v[76:77], v107 offset:29696
    ds_read_b64_tr_b16 v[78:79], v107 offset:30208
    ds_read_b64_tr_b16 v[80:81], v107 offset:25608
    ds_read_b64_tr_b16 v[82:83], v107 offset:26120
    ds_read_b64_tr_b16 v[84:85], v107 offset:29704
    ds_read_b64_tr_b16 v[86:87], v107 offset:30216
    ds_read_b64_tr_b16 v[88:89], v107 offset:25664
    ds_read_b64_tr_b16 v[90:91], v107 offset:26176
    ds_read_b64_tr_b16 v[92:93], v107 offset:29760
    ds_read_b64_tr_b16 v[94:95], v107 offset:30272
    ds_read_b64_tr_b16 v[96:97], v107 offset:25672
    ds_read_b64_tr_b16 v[98:99], v107 offset:26184
    ds_read_b64_tr_b16 v[100:101], v107 offset:29768
    ds_read_b64_tr_b16 v[102:103], v107 offset:30280
    s_mov_b32 s47, 1
    s_branch K2_PHASE
K2_GEMM:
    ds_bpermute_b32 v110, v108, v8
    ds_bpermute_b32 v111, v108, v9
    v_cvt_pk_bf16_f32 v28, v12, v13
    v_cvt_pk_bf16_f32 v29, v14, v15
    v_cvt_pk_bf16_f32 v30, v16, v17
    v_cvt_pk_bf16_f32 v31, v18, v19
    ds_write_b128 v104, v[28:31] offset:0
    v_cvt_pk_bf16_f32 v32, v20, v21
    v_cvt_pk_bf16_f32 v33, v22, v23
    v_cvt_pk_bf16_f32 v34, v24, v25
    v_cvt_pk_bf16_f32 v35, v26, v27
    ds_write_b128 v104, v[32:35] offset:1024
    ds_read_b128 v[40:43], v105
    ds_read_b128 v[44:47], v106
    s_lshl_b32 s45, s8, 7
    s_waitcnt lgkmcnt(1)
    v_cndmask_b32_e64 v110, v111, v110, s[74:75]
    v_mfma_f32_16x16x32_bf16 v[56:59], v[72:75], v[40:43], 0
    v_mfma_f32_16x16x32_bf16 v[60:63], v[80:83], v[40:43], 0
    v_mfma_f32_16x16x32_bf16 v[64:67], v[88:91], v[40:43], 0
    v_mfma_f32_16x16x32_bf16 v[68:71], v[96:99], v[40:43], 0
    v_lshlrev_b32 v110, 15, v110
    s_waitcnt lgkmcnt(0)
    v_mfma_f32_16x16x32_bf16 v[56:59], v[76:79], v[44:47], v[56:59]
    v_mfma_f32_16x16x32_bf16 v[60:63], v[84:87], v[44:47], v[60:63]
    v_mfma_f32_16x16x32_bf16 v[64:67], v[92:95], v[44:47], v[64:67]
    v_mfma_f32_16x16x32_bf16 v[68:71], v[100:103], v[44:47], v[68:71]
    v_add3_u32 v107, v110, s45, v109
    s_nop 4
    v_cvt_pk_bf16_f32 v48, v56, v57
    v_cvt_pk_bf16_f32 v49, v58, v59
    v_cvt_pk_bf16_f32 v50, v60, v61
    v_cvt_pk_bf16_f32 v51, v62, v63
    buffer_store_dwordx4 v[48:51], v107, s[28:31], 0 offen sc1
    v_cvt_pk_bf16_f32 v52, v64, v65
    v_cvt_pk_bf16_f32 v53, v66, v67
    s_nop 1
    v_cvt_pk_bf16_f32 v54, v68, v69
    v_cvt_pk_bf16_f32 v55, v70, v71
    buffer_store_dwordx4 v[52:55], v107, s[28:31], 0 offen offset:64 sc1
K2_END:
    s_endpgm
K2S_BF:
    s_cmp_eq_u32 s76, 0
    s_cbranch_scc1 K2S_BR
    s_sub_u32 s76, s76, 1
    s_barrier
    s_branch K2S_BF
K2S_BS:
    s_cmp_eq_u32 s76, 0
    s_cbranch_scc1 K2S_BR
    s_sub_u32 s76, s76, 1
    s_barrier
    s_sub_u32 s80, s80, s78
    s_cmp_ge_i32 s80, s78
    s_cbranch_scc1 K2S_BS
K2S_BR:
    s_setpc_b64 s[84:85]
GPOLL:
    s_mov_b64 s[72:73], exec
    s_mov_b64 exec, 15
    s_lshr_b32 s45, s2, 2
    s_and_b32 s45, s45, 15
    v_lshrrev_b32 v116, 2, v1
    v_mul_u32_u24 v116, 8, v116
    v_add_u32 v116, s45, v116
    v_and_b32 v116, 15, v116
    v_lshlrev_b32 v116, 2, v116
    v_and_b32 v117, 3, v1
    v_add_u32 v116, v116, v117
    v_lshlrev_b32 v116, 7, v116
    v_add_u32 v116, 1966080, v116
    s_mov_b32 s46, 16000000
G2_POLL:
    global_load_dword v118, v116, s[6:7] sc1
    s_waitcnt vmcnt(0)
    v_readlane_b32 s12, v118, 0
    v_readlane_b32 s13, v118, 1
    s_add_u32 s11, s12, s13
    v_readlane_b32 s14, v118, 2
    s_add_u32 s11, s11, s14
    v_readlane_b32 s15, v118, 3
    s_add_u32 s11, s11, s15
    s_cmp_ge_u32 s11, 256
    s_cbranch_scc1 G2_POLLED
    s_sleep 6
    s_sub_u32 s46, s46, 1
    s_cmp_eq_u32 s46, 0
    s_cbranch_scc0 G2_POLL
G2_POLLED:
    s_mov_b64 exec, s[72:73]
    s_setpc_b64 s[84:85]
    s_endpgm
K2_CODE_END:
.section .rodata,"a"
.p2align 6
.amdhsa_kernel sgc_part_kernel
  .amdhsa_next_free_vgpr 88
  .amdhsa_next_free_sgpr 64
  .amdhsa_accum_offset 88
  .amdhsa_group_segment_fixed_size 0
  .amdhsa_kernarg_size 64
  .amdhsa_user_sgpr_count 2
  .amdhsa_user_sgpr_kernarg_segment_ptr 1
  .amdhsa_system_sgpr_workgroup_id_x 1
.end_amdhsa_kernel
.p2align 6
.amdhsa_kernel sgc_prop_kernel
  .amdhsa_next_free_vgpr 128
  .amdhsa_next_free_sgpr 102
  .amdhsa_accum_offset 128
  .amdhsa_group_segment_fixed_size 0
  .amdhsa_kernarg_size 64
  .amdhsa_user_sgpr_count 2
  .amdhsa_user_sgpr_kernarg_segment_ptr 1
  .amdhsa_system_sgpr_workgroup_id_x 1
.end_amdhsa_kernel
.p2align 6
```
